```python
import torch

def _softmax(x, axis=-1):
    return torch.softmax(x, dim=axis)
def _gelu(x):
    return torch.nn.functional.gelu(x, approximate="tanh")
def _silu(x):
    return torch.nn.functional.silu(x)
def _sigmoid(x):
    return torch.sigmoid(x)
def _layernorm(x, axis=-1, eps=1e-5):
    m = x.mean(dim=axis, keepdim=True)
    v = x.var(dim=axis, keepdim=True, unbiased=False)
    return (x - m) / torch.sqrt(v + eps)
def _scatter_add(tgt, idx, src, axis=0):
    return tgt.clone().index_add_(axis, idx, src)
def _segment_sum(src, seg, n):
    out = torch.zeros((n,) + src.shape[1:], dtype=src.dtype)
    return out.index_add_(0, seg, src)
def _pad(x, pw):
    flat = tuple(v for pair in reversed(pw) for v in pair)
    return torch.nn.functional.pad(x, flat)

kernel_name = 'standalone__grn__sampling'

def setup_inputs():

    _w = (lambda a: (lambda t: t.to(torch.bfloat16) if t.is_floating_point() else t)(torch.as_tensor(a)))
    B, S, D = 1024, 32, 576
    return {
        "x": _w((lambda *s: torch.randn(*s, dtype=torch.bfloat16) * 0.05)(B, S, D)),
        "g": _w((lambda *s: torch.randn(*s, dtype=torch.bfloat16) * 0.4)(D) * 0.1),
        "b": _w((lambda *s: torch.randn(*s, dtype=torch.bfloat16) * 0.1)(D) * 0.1),
    }

def reference(x, g, b):
    gx = torch.sqrt((x * x).sum(axis=-2, keepdims=True))
    nx = gx / (gx.mean(axis=-1, keepdims=True) + 1e-6)
    return g * (x * nx) + b + x
```

```asm
; @launch grid=(1024,1,1) block=(256,1,1) lds=10240
.amdgcn_target "amdgcn-amd-amdhsa--gfx950"
.text
.globl standalone__grn__sampling_kernel
.p2align 8
.type standalone__grn__sampling_kernel,@function
standalone__grn__sampling_kernel:
  s_setprio 3
  s_load_dwordx2 s[4:5], s[0:1], 0
  s_load_dwordx2 s[8:9], s[0:1], 8
  s_load_dwordx2 s[12:13], s[0:1], 16
  s_load_dwordx2 s[16:17], s[0:1], 24
  s_cmp_ge_u32 s2, 1024
  s_cbranch_scc1 L_end
  s_mov_b32 s23, s2
  s_mul_i32 s23, s23, 36864
  v_and_b32 v4, 63, v0
  v_lshrrev_b32 v3, 6, v0
  v_mul_u32_u24 v6, 9216, v3
  v_add_u32 v6, s23, v6
  v_lshl_add_u32 v1, v4, 4, v6
  v_lshrrev_b32 v7, 3, v4
  v_mul_u32_u24 v8, 1152, v7
  v_and_b32 v5, 7, v4
  v_lshlrev_b32 v5, 4, v5
  v_add3_u32 v2, v8, v6, v5
  v_add_u32 v2, 1024, v2
  v_lshlrev_b32 v9, 4, v4
  v_add_u32 v10, 1024, v5
  v_lshl_add_u32 v11, v7, 1, v10
  s_mov_b32 s6, 37748736
  s_mov_b32 s7, 0x20000
  s_mov_b32 s10, 1152
  s_mov_b32 s11, 0x20000
  s_mov_b32 s14, 1152
  s_mov_b32 s15, 0x20000
  s_mov_b32 s18, 37748736
  s_mov_b32 s19, 0x20000
  s_movk_i32 s26, 4608
  s_mov_b32 s27, 0xffff0000
  s_waitcnt lgkmcnt(0)
  buffer_load_dwordx4 v[60:63], v1, s[4:7], 0 offen offset:0 nt
  buffer_load_dwordx4 v[64:67], v1, s[4:7], 0 offen offset:1152 nt
  buffer_load_dwordx4 v[68:71], v1, s[4:7], 0 offen offset:2304 nt
  buffer_load_dwordx4 v[72:75], v1, s[4:7], 0 offen offset:3456 nt
  buffer_load_dwordx4 v[76:79], v1, s[4:7], s26 offen offset:0 nt
  buffer_load_dwordx4 v[80:83], v1, s[4:7], s26 offen offset:1152 nt
  buffer_load_dwordx4 v[84:87], v1, s[4:7], s26 offen offset:2304 nt
  buffer_load_dwordx4 v[88:91], v1, s[4:7], s26 offen offset:3456 nt
  buffer_load_dwordx4 v[92:95], v2, s[4:7], 0 offen nt
  buffer_load_dwordx4 v[30:33], v9, s[8:11], 0 offen
  buffer_load_ushort v42, v11, s[8:11], 0 offen
  buffer_load_dwordx4 v[34:37], v9, s[12:15], 0 offen
  buffer_load_dwordx4 v[38:41], v10, s[12:15], 0 offen
  s_waitcnt vmcnt(12)
  v_lshlrev_b32 v6, 16, v60
  v_and_b32 v7, s27, v60
  v_pk_mul_f32 v[14:15], v[6:7], v[6:7]
  v_lshlrev_b32 v8, 16, v61
  v_and_b32 v9, s27, v61
  v_pk_mul_f32 v[16:17], v[8:9], v[8:9]
  v_lshlrev_b32 v10, 16, v62
  v_and_b32 v11, s27, v62
  v_pk_mul_f32 v[18:19], v[10:11], v[10:11]
  v_lshlrev_b32 v12, 16, v63
  v_and_b32 v13, s27, v63
  v_pk_mul_f32 v[20:21], v[12:13], v[12:13]
  s_waitcnt vmcnt(11)
  v_lshlrev_b32 v6, 16, v64
  v_and_b32 v7, s27, v64
  v_pk_fma_f32 v[14:15], v[6:7], v[6:7], v[14:15]
  v_lshlrev_b32 v8, 16, v65
  v_and_b32 v9, s27, v65
  v_pk_fma_f32 v[16:17], v[8:9], v[8:9], v[16:17]
  v_lshlrev_b32 v10, 16, v66
  v_and_b32 v11, s27, v66
  v_pk_fma_f32 v[18:19], v[10:11], v[10:11], v[18:19]
  v_lshlrev_b32 v12, 16, v67
  v_and_b32 v13, s27, v67
  v_pk_fma_f32 v[20:21], v[12:13], v[12:13], v[20:21]
  s_waitcnt vmcnt(10)
  v_lshlrev_b32 v6, 16, v68
  v_and_b32 v7, s27, v68
  v_pk_fma_f32 v[14:15], v[6:7], v[6:7], v[14:15]
  v_lshlrev_b32 v8, 16, v69
  v_and_b32 v9, s27, v69
  v_pk_fma_f32 v[16:17], v[8:9], v[8:9], v[16:17]
  v_lshlrev_b32 v10, 16, v70
  v_and_b32 v11, s27, v70
  v_pk_fma_f32 v[18:19], v[10:11], v[10:11], v[18:19]
  v_lshlrev_b32 v12, 16, v71
  v_and_b32 v13, s27, v71
  v_pk_fma_f32 v[20:21], v[12:13], v[12:13], v[20:21]
  s_waitcnt vmcnt(9)
  v_lshlrev_b32 v6, 16, v72
  v_and_b32 v7, s27, v72
  v_pk_fma_f32 v[14:15], v[6:7], v[6:7], v[14:15]
  v_lshlrev_b32 v8, 16, v73
  v_and_b32 v9, s27, v73
  v_pk_fma_f32 v[16:17], v[8:9], v[8:9], v[16:17]
  v_lshlrev_b32 v10, 16, v74
  v_and_b32 v11, s27, v74
  v_pk_fma_f32 v[18:19], v[10:11], v[10:11], v[18:19]
  v_lshlrev_b32 v12, 16, v75
  v_and_b32 v13, s27, v75
  v_pk_fma_f32 v[20:21], v[12:13], v[12:13], v[20:21]
  s_waitcnt vmcnt(8)
  v_lshlrev_b32 v6, 16, v76
  v_and_b32 v7, s27, v76
  v_pk_fma_f32 v[14:15], v[6:7], v[6:7], v[14:15]
  v_lshlrev_b32 v8, 16, v77
  v_and_b32 v9, s27, v77
  v_pk_fma_f32 v[16:17], v[8:9], v[8:9], v[16:17]
  v_lshlrev_b32 v10, 16, v78
  v_and_b32 v11, s27, v78
  v_pk_fma_f32 v[18:19], v[10:11], v[10:11], v[18:19]
  v_lshlrev_b32 v12, 16, v79
  v_and_b32 v13, s27, v79
  v_pk_fma_f32 v[20:21], v[12:13], v[12:13], v[20:21]
  s_waitcnt vmcnt(7)
  v_lshlrev_b32 v6, 16, v80
  v_and_b32 v7, s27, v80
  v_pk_fma_f32 v[14:15], v[6:7], v[6:7], v[14:15]
  v_lshlrev_b32 v8, 16, v81
  v_and_b32 v9, s27, v81
  v_pk_fma_f32 v[16:17], v[8:9], v[8:9], v[16:17]
  v_lshlrev_b32 v10, 16, v82
  v_and_b32 v11, s27, v82
  v_pk_fma_f32 v[18:19], v[10:11], v[10:11], v[18:19]
  v_lshlrev_b32 v12, 16, v83
  v_and_b32 v13, s27, v83
  v_pk_fma_f32 v[20:21], v[12:13], v[12:13], v[20:21]
  s_waitcnt vmcnt(6)
  v_lshlrev_b32 v6, 16, v84
  v_and_b32 v7, s27, v84
  v_pk_fma_f32 v[14:15], v[6:7], v[6:7], v[14:15]
  v_lshlrev_b32 v8, 16, v85
  v_and_b32 v9, s27, v85
  v_pk_fma_f32 v[16:17], v[8:9], v[8:9], v[16:17]
  v_lshlrev_b32 v10, 16, v86
  v_and_b32 v11, s27, v86
  v_pk_fma_f32 v[18:19], v[10:11], v[10:11], v[18:19]
  v_lshlrev_b32 v12, 16, v87
  v_and_b32 v13, s27, v87
  v_pk_fma_f32 v[20:21], v[12:13], v[12:13], v[20:21]
  s_waitcnt vmcnt(5)
  v_lshlrev_b32 v6, 16, v88
  v_and_b32 v7, s27, v88
  v_pk_fma_f32 v[14:15], v[6:7], v[6:7], v[14:15]
  v_lshlrev_b32 v8, 16, v89
  v_and_b32 v9, s27, v89
  v_pk_fma_f32 v[16:17], v[8:9], v[8:9], v[16:17]
  v_lshlrev_b32 v10, 16, v90
  v_and_b32 v11, s27, v90
  v_pk_fma_f32 v[18:19], v[10:11], v[10:11], v[18:19]
  v_lshlrev_b32 v12, 16, v91
  v_and_b32 v13, s27, v91
  v_pk_fma_f32 v[20:21], v[12:13], v[12:13], v[20:21]
  s_waitcnt vmcnt(4)
  v_lshlrev_b32 v6, 16, v92
  v_and_b32 v7, s27, v92
  v_pk_mul_f32 v[22:23], v[6:7], v[6:7]
  v_lshlrev_b32 v8, 16, v93
  v_and_b32 v9, s27, v93
  v_pk_mul_f32 v[24:25], v[8:9], v[8:9]
  v_lshlrev_b32 v10, 16, v94
  v_and_b32 v11, s27, v94
  v_pk_mul_f32 v[26:27], v[10:11], v[10:11]
  v_lshlrev_b32 v12, 16, v95
  v_and_b32 v13, s27, v95
  v_pk_mul_f32 v[28:29], v[12:13], v[12:13]
  v_lshlrev_b32 v6, 11, v3
  v_lshl_add_u32 v6, v4, 4, v6
  ds_write_b128 v6, v[14:17]
  ds_write_b128 v6, v[18:21] offset:1024
  v_permlane32_swap_b32 v22, v26
  v_permlane32_swap_b32 v23, v27
  v_permlane32_swap_b32 v24, v28
  v_permlane32_swap_b32 v25, v29
  v_add_f32 v22, v22, v26
  v_add_f32 v23, v23, v27
  v_add_f32 v24, v24, v28
  v_add_f32 v25, v25, v29
  v_lshlrev_b32 v7, 2, v3
  v_lshl_add_u32 v7, v4, 4, v7
  v_permlane16_swap_b32 v22, v24
  v_permlane16_swap_b32 v23, v25
  v_add_f32 v22, v22, v24
  v_add_f32 v23, v23, v25
  v_lshlrev_b32 v6, 4, v4
  s_nop 0
  v_add_f32_dpp v24, v22, v22 row_ror:8 row_mask:0xf bank_mask:0x3
  v_add_f32_dpp v24, v23, v23 row_ror:8 row_mask:0xf bank_mask:0xc
  ds_write_b32 v7, v24 offset:8192
  s_waitcnt lgkmcnt(0)
  s_barrier
  ds_read_b128 v[44:47], v6 offset:0
  ds_read_b128 v[48:51], v6 offset:1024
  ds_read_b128 v[52:55], v6 offset:2048
  ds_read_b128 v[56:59], v6 offset:3072
  ds_read_b128 v[8:11], v6 offset:8192
  ds_read_b128 v[26:29], v6 offset:4096
  s_waitcnt lgkmcnt(2)
  v_pk_add_f32 v[14:15], v[44:45], v[52:53]
  v_pk_add_f32 v[16:17], v[46:47], v[54:55]
  v_pk_add_f32 v[18:19], v[48:49], v[56:57]
  v_pk_add_f32 v[20:21], v[50:51], v[58:59]
  ds_read_b128 v[44:47], v6 offset:5120
  ds_read_b128 v[48:51], v6 offset:6144
  ds_read_b128 v[52:55], v6 offset:7168
  s_waitcnt lgkmcnt(4)
  v_add_f32 v8, v8, v9
  v_add_f32 v10, v10, v11
  v_add_f32 v24, v8, v10
  s_waitcnt lgkmcnt(1)
  v_pk_add_f32 v[26:27], v[26:27], v[48:49]
  v_pk_add_f32 v[28:29], v[28:29], v[50:51]
  v_pk_add_f32 v[14:15], v[14:15], v[26:27]
  v_pk_add_f32 v[16:17], v[16:17], v[28:29]
  s_waitcnt lgkmcnt(0)
  v_pk_add_f32 v[44:45], v[44:45], v[52:53]
  v_pk_add_f32 v[46:47], v[46:47], v[54:55]
  v_pk_add_f32 v[18:19], v[18:19], v[44:45]
  v_pk_add_f32 v[20:21], v[20:21], v[46:47]
  v_sqrt_f32 v24, v24
  v_sqrt_f32 v14, v14
  v_sqrt_f32 v15, v15
  v_sqrt_f32 v16, v16
  v_sqrt_f32 v17, v17
  v_sqrt_f32 v18, v18
  v_sqrt_f32 v19, v19
  v_sqrt_f32 v20, v20
  v_sqrt_f32 v21, v21
  s_nop 0
  v_add_f32 v6, v14, v15
  v_add_f32 v7, v16, v17
  v_add_f32 v8, v18, v19
  v_add_f32 v9, v20, v21
  v_add_f32 v6, v6, v7
  v_add_f32 v8, v8, v9
  v_add_f32 v6, v6, v24
  v_add_f32 v6, v6, v8
  s_waitcnt vmcnt(0)
  v_lshlrev_b32 v44, 16, v30
  v_and_b32 v45, s27, v30
  v_add_f32_dpp v6, v6, v6 row_ror:8 row_mask:0xf bank_mask:0xf
  v_lshlrev_b32 v46, 16, v31
  v_and_b32 v47, s27, v31
  v_add_f32_dpp v6, v6, v6 row_ror:4 row_mask:0xf bank_mask:0xf
  v_lshlrev_b32 v48, 16, v32
  v_and_b32 v49, s27, v32
  v_add_f32_dpp v6, v6, v6 row_ror:2 row_mask:0xf bank_mask:0xf
  v_lshlrev_b32 v50, 16, v33
  v_and_b32 v51, s27, v33
  v_add_f32_dpp v6, v6, v6 row_ror:1 row_mask:0xf bank_mask:0xf
  v_mov_b32 v7, v6
  v_lshlrev_b32 v42, 16, v42
  v_and_b32 v8, 7, v4
  v_permlane16_swap_b32 v6, v7
  v_add_f32 v6, v6, v7
  v_mov_b32 v7, v6
  v_lshlrev_b32 v8, 5, v8
  v_lshl_add_u32 v8, v3, 8, v8
  v_permlane32_swap_b32 v6, v7
  v_add_f32 v6, v6, v7
  v_mov_b32 v7, 0x358637bd
  s_mov_b32 s28, 0x3ae38e39
  v_fma_f32 v6, v6, s28, v7
  v_rcp_f32 v6, v6
  v_lshrrev_b32 v9, 3, v4
  v_lshl_add_u32 v9, v9, 2, v8
  v_mul_f32 v24, v24, v6
  v_fma_f32 v24, v42, v24, 1.0
  ds_write_b32 v9, v24 offset:9216
  v_mul_f32 v14, v14, v6
  v_mul_f32 v15, v15, v6
  v_mul_f32 v16, v16, v6
  v_mul_f32 v17, v17, v6
  v_mul_f32 v18, v18, v6
  v_mul_f32 v19, v19, v6
  v_mul_f32 v20, v20, v6
  v_mul_f32 v21, v21, v6
  v_fma_f32 v44, v44, v14, 1.0
  v_fma_f32 v45, v45, v15, 1.0
  v_fma_f32 v46, v46, v16, 1.0
  v_fma_f32 v47, v47, v17, 1.0
  v_fma_f32 v48, v48, v18, 1.0
  v_fma_f32 v49, v49, v19, 1.0
  v_fma_f32 v50, v50, v20, 1.0
  v_fma_f32 v51, v51, v21, 1.0
  s_waitcnt lgkmcnt(0)
  ds_read_b128 v[52:55], v8 offset:9216
  ds_read_b128 v[56:59], v8 offset:9232
  v_lshlrev_b32 v14, 16, v34
  v_and_b32 v15, s27, v34
  v_lshlrev_b32 v16, 16, v35
  v_and_b32 v17, s27, v35
  v_lshlrev_b32 v18, 16, v36
  v_and_b32 v19, s27, v36
  v_lshlrev_b32 v20, 16, v37
  v_and_b32 v21, s27, v37
  v_lshlrev_b32 v22, 16, v38
  v_and_b32 v23, s27, v38
  v_lshlrev_b32 v24, 16, v39
  v_and_b32 v25, s27, v39
  v_lshlrev_b32 v26, 16, v40
  v_and_b32 v27, s27, v40
  v_lshlrev_b32 v28, 16, v41
  v_and_b32 v29, s27, v41
  v_lshlrev_b32 v6, 16, v60
  v_and_b32 v7, s27, v60
  v_pk_fma_f32 v[6:7], v[6:7], v[44:45], v[14:15]
  v_cvt_pk_bf16_f32 v60, v6, v7
  v_lshlrev_b32 v8, 16, v61
  v_and_b32 v9, s27, v61
  v_pk_fma_f32 v[8:9], v[8:9], v[46:47], v[16:17]
  v_cvt_pk_bf16_f32 v61, v8, v9
  v_lshlrev_b32 v10, 16, v62
  v_and_b32 v11, s27, v62
  v_pk_fma_f32 v[10:11], v[10:11], v[48:49], v[18:19]
  v_cvt_pk_bf16_f32 v62, v10, v11
  v_lshlrev_b32 v12, 16, v63
  v_and_b32 v13, s27, v63
  v_pk_fma_f32 v[12:13], v[12:13], v[50:51], v[20:21]
  v_cvt_pk_bf16_f32 v63, v12, v13
  v_lshlrev_b32 v6, 16, v64
  v_and_b32 v7, s27, v64
  v_pk_fma_f32 v[6:7], v[6:7], v[44:45], v[14:15]
  v_cvt_pk_bf16_f32 v64, v6, v7
  v_lshlrev_b32 v8, 16, v65
  v_and_b32 v9, s27, v65
  v_pk_fma_f32 v[8:9], v[8:9], v[46:47], v[16:17]
  v_cvt_pk_bf16_f32 v65, v8, v9
  v_lshlrev_b32 v10, 16, v66
  v_and_b32 v11, s27, v66
  v_pk_fma_f32 v[10:11], v[10:11], v[48:49], v[18:19]
  v_cvt_pk_bf16_f32 v66, v10, v11
  v_lshlrev_b32 v12, 16, v67
  v_and_b32 v13, s27, v67
  v_pk_fma_f32 v[12:13], v[12:13], v[50:51], v[20:21]
  v_cvt_pk_bf16_f32 v67, v12, v13
  v_lshlrev_b32 v6, 16, v68
  v_and_b32 v7, s27, v68
  v_pk_fma_f32 v[6:7], v[6:7], v[44:45], v[14:15]
  v_cvt_pk_bf16_f32 v68, v6, v7
  v_lshlrev_b32 v8, 16, v69
  v_and_b32 v9, s27, v69
  v_pk_fma_f32 v[8:9], v[8:9], v[46:47], v[16:17]
  v_cvt_pk_bf16_f32 v69, v8, v9
  v_lshlrev_b32 v10, 16, v70
  v_and_b32 v11, s27, v70
  v_pk_fma_f32 v[10:11], v[10:11], v[48:49], v[18:19]
  v_cvt_pk_bf16_f32 v70, v10, v11
  v_lshlrev_b32 v12, 16, v71
  v_and_b32 v13, s27, v71
  v_pk_fma_f32 v[12:13], v[12:13], v[50:51], v[20:21]
  v_cvt_pk_bf16_f32 v71, v12, v13
  v_lshlrev_b32 v6, 16, v72
  v_and_b32 v7, s27, v72
  v_pk_fma_f32 v[6:7], v[6:7], v[44:45], v[14:15]
  v_cvt_pk_bf16_f32 v72, v6, v7
  v_lshlrev_b32 v8, 16, v73
  v_and_b32 v9, s27, v73
  v_pk_fma_f32 v[8:9], v[8:9], v[46:47], v[16:17]
  v_cvt_pk_bf16_f32 v73, v8, v9
  v_lshlrev_b32 v10, 16, v74
  v_and_b32 v11, s27, v74
  v_pk_fma_f32 v[10:11], v[10:11], v[48:49], v[18:19]
  v_cvt_pk_bf16_f32 v74, v10, v11
  v_lshlrev_b32 v12, 16, v75
  v_and_b32 v13, s27, v75
  v_pk_fma_f32 v[12:13], v[12:13], v[50:51], v[20:21]
  v_cvt_pk_bf16_f32 v75, v12, v13
  v_lshlrev_b32 v6, 16, v76
  v_and_b32 v7, s27, v76
  v_pk_fma_f32 v[6:7], v[6:7], v[44:45], v[14:15]
  v_cvt_pk_bf16_f32 v76, v6, v7
  v_lshlrev_b32 v8, 16, v77
  v_and_b32 v9, s27, v77
  v_pk_fma_f32 v[8:9], v[8:9], v[46:47], v[16:17]
  v_cvt_pk_bf16_f32 v77, v8, v9
  v_lshlrev_b32 v10, 16, v78
  v_and_b32 v11, s27, v78
  v_pk_fma_f32 v[10:11], v[10:11], v[48:49], v[18:19]
  v_cvt_pk_bf16_f32 v78, v10, v11
  v_lshlrev_b32 v12, 16, v79
  v_and_b32 v13, s27, v79
  v_pk_fma_f32 v[12:13], v[12:13], v[50:51], v[20:21]
  v_cvt_pk_bf16_f32 v79, v12, v13
  v_lshlrev_b32 v6, 16, v80
  v_and_b32 v7, s27, v80
  v_pk_fma_f32 v[6:7], v[6:7], v[44:45], v[14:15]
  v_cvt_pk_bf16_f32 v80, v6, v7
  v_lshlrev_b32 v8, 16, v81
  v_and_b32 v9, s27, v81
  v_pk_fma_f32 v[8:9], v[8:9], v[46:47], v[16:17]
  v_cvt_pk_bf16_f32 v81, v8, v9
  v_lshlrev_b32 v10, 16, v82
  v_and_b32 v11, s27, v82
  v_pk_fma_f32 v[10:11], v[10:11], v[48:49], v[18:19]
  v_cvt_pk_bf16_f32 v82, v10, v11
  v_lshlrev_b32 v12, 16, v83
  v_and_b32 v13, s27, v83
  v_pk_fma_f32 v[12:13], v[12:13], v[50:51], v[20:21]
  v_cvt_pk_bf16_f32 v83, v12, v13
  v_lshlrev_b32 v6, 16, v84
  v_and_b32 v7, s27, v84
  v_pk_fma_f32 v[6:7], v[6:7], v[44:45], v[14:15]
  v_cvt_pk_bf16_f32 v84, v6, v7
  v_lshlrev_b32 v8, 16, v85
  v_and_b32 v9, s27, v85
  v_pk_fma_f32 v[8:9], v[8:9], v[46:47], v[16:17]
  v_cvt_pk_bf16_f32 v85, v8, v9
  v_lshlrev_b32 v10, 16, v86
  v_and_b32 v11, s27, v86
  v_pk_fma_f32 v[10:11], v[10:11], v[48:49], v[18:19]
  v_cvt_pk_bf16_f32 v86, v10, v11
  v_lshlrev_b32 v12, 16, v87
  v_and_b32 v13, s27, v87
  v_pk_fma_f32 v[12:13], v[12:13], v[50:51], v[20:21]
  v_cvt_pk_bf16_f32 v87, v12, v13
  v_lshlrev_b32 v6, 16, v88
  v_and_b32 v7, s27, v88
  v_pk_fma_f32 v[6:7], v[6:7], v[44:45], v[14:15]
  v_cvt_pk_bf16_f32 v88, v6, v7
  v_lshlrev_b32 v8, 16, v89
  v_and_b32 v9, s27, v89
  v_pk_fma_f32 v[8:9], v[8:9], v[46:47], v[16:17]
  v_cvt_pk_bf16_f32 v89, v8, v9
  v_lshlrev_b32 v10, 16, v90
  v_and_b32 v11, s27, v90
  v_pk_fma_f32 v[10:11], v[10:11], v[48:49], v[18:19]
  v_cvt_pk_bf16_f32 v90, v10, v11
  v_lshlrev_b32 v12, 16, v91
  v_and_b32 v13, s27, v91
  v_pk_fma_f32 v[12:13], v[12:13], v[50:51], v[20:21]
  v_cvt_pk_bf16_f32 v91, v12, v13
  s_waitcnt lgkmcnt(0)
  v_lshlrev_b32 v6, 16, v92
  v_and_b32 v7, s27, v92
  v_pk_fma_f32 v[6:7], v[6:7], v[52:53], v[22:23]
  v_cvt_pk_bf16_f32 v92, v6, v7
  v_lshlrev_b32 v8, 16, v93
  v_and_b32 v9, s27, v93
  v_pk_fma_f32 v[8:9], v[8:9], v[54:55], v[24:25]
  v_cvt_pk_bf16_f32 v93, v8, v9
  v_lshlrev_b32 v10, 16, v94
  v_and_b32 v11, s27, v94
  v_pk_fma_f32 v[10:11], v[10:11], v[56:57], v[26:27]
  v_cvt_pk_bf16_f32 v94, v10, v11
  v_lshlrev_b32 v12, 16, v95
  v_and_b32 v13, s27, v95
  v_pk_fma_f32 v[12:13], v[12:13], v[58:59], v[28:29]
  v_cvt_pk_bf16_f32 v95, v12, v13
  s_setprio 0
  buffer_store_dwordx4 v[60:63], v1, s[16:19], 0 offen offset:0 sc0 sc1
  buffer_store_dwordx4 v[64:67], v1, s[16:19], 0 offen offset:1152 sc0 sc1
  buffer_store_dwordx4 v[68:71], v1, s[16:19], 0 offen offset:2304 sc0 sc1
  buffer_store_dwordx4 v[72:75], v1, s[16:19], 0 offen offset:3456 sc0 sc1
  buffer_store_dwordx4 v[76:79], v1, s[16:19], s26 offen offset:0 sc0 sc1
  buffer_store_dwordx4 v[80:83], v1, s[16:19], s26 offen offset:1152 sc0 sc1
  buffer_store_dwordx4 v[84:87], v1, s[16:19], s26 offen offset:2304 sc0 sc1
  buffer_store_dwordx4 v[88:91], v1, s[16:19], s26 offen offset:3456 sc0 sc1
  buffer_store_dwordx4 v[92:95], v2, s[16:19], 0 offen sc0 sc1
L_end:
  s_endpgm
.section .rodata,"a"
.p2align 6
.amdhsa_kernel standalone__grn__sampling_kernel
  .amdhsa_next_free_vgpr 104
  .amdhsa_next_free_sgpr 32
  .amdhsa_accum_offset 104
  .amdhsa_group_segment_fixed_size 0
  .amdhsa_kernarg_size 48
  .amdhsa_user_sgpr_count 2
  .amdhsa_user_sgpr_kernarg_segment_ptr 1
  .amdhsa_system_sgpr_workgroup_id_x 1
  .amdhsa_float_denorm_mode_32 3
.end_amdhsa_kernel
```
